```python
import torch

def _softmax(x, axis=-1):
    return torch.softmax(x, dim=axis)
def _gelu(x):
    return torch.nn.functional.gelu(x, approximate="tanh")
def _silu(x):
    return torch.nn.functional.silu(x)
def _sigmoid(x):
    return torch.sigmoid(x)
def _layernorm(x, axis=-1, eps=1e-5):
    m = x.mean(dim=axis, keepdim=True)
    v = x.var(dim=axis, keepdim=True, unbiased=False)
    return (x - m) / torch.sqrt(v + eps)
def _scatter_add(tgt, idx, src, axis=0):
    return tgt.clone().index_add_(axis, idx, src)
def _segment_sum(src, seg, n):
    out = torch.zeros((n,) + src.shape[1:], dtype=src.dtype)
    return out.index_add_(0, seg, src)
def _pad(x, pw):
    flat = tuple(v for pair in reversed(pw) for v in pair)
    return torch.nn.functional.pad(x, flat)

kernel_name = 'standalone__softmax_full_bidir__decode'

def setup_inputs():

    _w = (lambda a: (lambda t: t.to(torch.bfloat16) if t.is_floating_point() else t)(torch.as_tensor(a)))
    B, H, Sq, Skv, Dh = 8, 32, 1, 4096, 128
    return {
        "q": _w((lambda *s: torch.randn(*s, dtype=torch.bfloat16) * 0.8)(B, H, Sq, Dh)),
        "k": _w((lambda *s: torch.randn(*s, dtype=torch.bfloat16) * 0.8)(B, H, Skv, Dh)),
        "v": _w((lambda *s: torch.randn(*s, dtype=torch.bfloat16) * 0.05)(B, H, Skv, Dh)),
    }

def reference(q, k, v):
    scale = q.shape[-1] ** -0.5
    scores = torch.einsum('bhqd,bhkd->bhqk', q, k) * scale
    attn = _softmax(scores, axis=-1)
    return torch.einsum('bhqk,bhkd->bhqd', attn, v)
```

```asm
; @launch grid=(256,1,1) block=(1024,1,1) lds=8336
.amdgcn_target "amdgcn-amd-amdhsa--gfx950"
.text
.globl standalone__softmax_full_bidir__decode_kernel
.p2align 8
.type standalone__softmax_full_bidir__decode_kernel,@function
standalone__softmax_full_bidir__decode_kernel:
    s_cmp_ge_u32 s2, 256
    s_cbranch_scc1 L_done
    s_memrealtime s[44:45]
    s_load_dwordx4 s[4:7], s[0:1], 0
    s_load_dwordx4 s[8:11], s[0:1], 16
    v_lshrrev_b32 v1, 6, v0
    v_and_b32 v2, 63, v0
    v_readfirstlane_b32 s3, v1
    v_and_b32 v3, 15, v2
    v_lshlrev_b32 v3, 4, v3
    v_lshlrev_b32 v2, 4, v2
    s_lshl_b32 s12, s2, 20
    s_lshr_b32 s13, s2, 12
    s_lshl_b32 s14, s2, 8
    s_mov_b32 s34, 0x3e0293ee
    s_mov_b32 s37, 0xffff0000
    v_mov_b32 v30, 8320
    v_mov_b32 v28, 0x10000010
    v_mov_b32 v29, 0
    v_mov_b32 v31, 1
    s_mov_b32 s88, 16
    s_mul_i32 s32, s3, 4096
    s_add_u32 s64, s32, 0
    s_cmp_lg_u32 s3, 0
    s_cbranch_scc1 L_noinit
    ds_write_b64 v30, v[28:29]
L_noinit:
    s_waitcnt lgkmcnt(0)
    s_add_u32 s16, s4, s14
    s_addc_u32 s17, s5, 0
    s_mov_b32 s18, 256
    s_mov_b32 s19, 0x00020000
    s_add_u32 s20, s6, s12
    s_addc_u32 s21, s7, s13
    s_mov_b32 s22, 0x100000
    s_mov_b32 s23, 0x00020000
    s_add_u32 s24, s8, s12
    s_addc_u32 s25, s9, s13
    s_mov_b32 s26, 0x100000
    s_mov_b32 s27, 0x00020000
    s_add_u32 s28, s10, s14
    s_addc_u32 s29, s11, 0
    s_mov_b32 s30, 256
    s_mov_b32 s31, 0x00020000
    buffer_load_dwordx4 v[4:7], v3, s[16:19], 0 offen
    buffer_load_dwordx4 v[36:39], v2, s[20:23], s64 offen offset:0 nt
    buffer_load_dwordx4 v[40:43], v2, s[20:23], s64 offen offset:1024 nt
    buffer_load_dwordx4 v[44:47], v2, s[20:23], s64 offen offset:2048 nt
    buffer_load_dwordx4 v[48:51], v2, s[20:23], s64 offen offset:3072 nt
    v_mov_b32 v8, 0
    v_mov_b32 v9, 0
    v_mov_b32 v10, 0
    v_mov_b32 v11, 0
    v_mov_b32 v12, 0
    v_mov_b32 v13, 0
    v_mov_b32 v14, 0
    v_mov_b32 v15, 0
    v_mov_b32 v16, 0xff800000
    v_mov_b32 v17, 0
    s_barrier
    s_branch L_go
L_bound:
    s_waitcnt lgkmcnt(0)
    s_cmp_lg_u32 s3, 0
    s_cbranch_scc1 L_noctl
    v_readfirstlane_b32 s35, v29
    s_sub_u32 s36, s46, s44
    s_mul_i32 s35, s35, 7200
    s_sub_i32 s36, s36, 200
    s_lshl_b32 s36, s36, 8
    s_sub_i32 s35, s35, s36
    s_mov_b32 s36, 16
    s_cmp_gt_i32 s35, -25600
    s_cselect_b32 s36, 10, s36
    s_cmp_gt_i32 s35, -12800
    s_cselect_b32 s36, 8, s36
    s_cmp_gt_i32 s35, 0
    s_cselect_b32 s36, 7, s36
    s_cmp_gt_i32 s35, 12800
    s_cselect_b32 s36, 6, s36
    s_cmp_gt_i32 s35, 25600
    s_cselect_b32 s36, 5, s36
    s_cmp_gt_i32 s35, 38400
    s_cselect_b32 s36, 4, s36
    s_cmp_gt_i32 s35, 64000
    s_cselect_b32 s36, 3, s36
    s_sub_i32 s35, s36, s88
    s_cmp_eq_u32 s35, 0
    s_cbranch_scc1 L_go
    s_mov_b32 s88, s36
    s_lshl_b32 s35, s35, 24
    v_mov_b32 v32, s35
    s_mov_b64 exec, 1
    ds_add_u32 v30, v32
    s_mov_b64 exec, -1
    s_branch L_go
L_noctl:
    v_readfirstlane_b32 s33, v28
    s_lshr_b32 s33, s33, 24
    s_cmp_ge_u32 s3, s33
    s_cbranch_scc1 L_park
L_go:
    s_mov_b64 exec, 1
    ds_add_rtn_u32 v28, v30, v31
    s_mov_b64 exec, -1
    s_waitcnt vmcnt(3)
    v_dot2_f32_bf16 v68, v36, v4, 0
    v_dot2_f32_bf16 v68, v37, v5, v68
    v_dot2_f32_bf16 v68, v38, v6, v68
    v_dot2_f32_bf16 v68, v39, v7, v68
    buffer_load_dwordx4 v[52:55], v2, s[24:27], s64 offen offset:0 nt
    s_waitcnt vmcnt(3)
    v_dot2_f32_bf16 v69, v40, v4, 0
    v_dot2_f32_bf16 v69, v41, v5, v69
    v_dot2_f32_bf16 v69, v42, v6, v69
    v_dot2_f32_bf16 v69, v43, v7, v69
    buffer_load_dwordx4 v[56:59], v2, s[24:27], s64 offen offset:1024 nt
    s_waitcnt vmcnt(3)
    v_dot2_f32_bf16 v70, v44, v4, 0
    v_dot2_f32_bf16 v70, v45, v5, v70
    v_dot2_f32_bf16 v70, v46, v6, v70
    v_dot2_f32_bf16 v70, v47, v7, v70
    buffer_load_dwordx4 v[60:63], v2, s[24:27], s64 offen offset:2048 nt
    s_waitcnt vmcnt(3)
    v_dot2_f32_bf16 v71, v48, v4, 0
    v_dot2_f32_bf16 v71, v49, v5, v71
    v_dot2_f32_bf16 v71, v50, v6, v71
    v_dot2_f32_bf16 v71, v51, v7, v71
    buffer_load_dwordx4 v[64:67], v2, s[24:27], s64 offen offset:3072 nt
    s_nop 1
    v_add_f32_dpp v68, v68, v68 quad_perm:[1,0,3,2] row_mask:0xf bank_mask:0xf
    v_add_f32_dpp v69, v69, v69 quad_perm:[1,0,3,2] row_mask:0xf bank_mask:0xf
    v_add_f32_dpp v70, v70, v70 quad_perm:[1,0,3,2] row_mask:0xf bank_mask:0xf
    v_add_f32_dpp v71, v71, v71 quad_perm:[1,0,3,2] row_mask:0xf bank_mask:0xf
    v_add_f32_dpp v68, v68, v68 quad_perm:[2,3,0,1] row_mask:0xf bank_mask:0xf
    v_add_f32_dpp v69, v69, v69 quad_perm:[2,3,0,1] row_mask:0xf bank_mask:0xf
    v_add_f32_dpp v70, v70, v70 quad_perm:[2,3,0,1] row_mask:0xf bank_mask:0xf
    v_add_f32_dpp v71, v71, v71 quad_perm:[2,3,0,1] row_mask:0xf bank_mask:0xf
    v_add_f32_dpp v68, v68, v68 row_half_mirror row_mask:0xf bank_mask:0xf
    v_add_f32_dpp v69, v69, v69 row_half_mirror row_mask:0xf bank_mask:0xf
    v_add_f32_dpp v70, v70, v70 row_half_mirror row_mask:0xf bank_mask:0xf
    v_add_f32_dpp v71, v71, v71 row_half_mirror row_mask:0xf bank_mask:0xf
    v_add_f32_dpp v68, v68, v68 row_mirror row_mask:0xf bank_mask:0xf
    v_add_f32_dpp v69, v69, v69 row_mirror row_mask:0xf bank_mask:0xf
    v_add_f32_dpp v70, v70, v70 row_mirror row_mask:0xf bank_mask:0xf
    v_add_f32_dpp v71, v71, v71 row_mirror row_mask:0xf bank_mask:0xf
    v_max3_f32 v26, v16, v68, v69
    v_max3_f32 v26, v26, v70, v71
    v_sub_f32 v27, v16, v26
    v_mul_f32 v27, s34, v27
    v_exp_f32 v27, v27
    v_mul_f32 v1, s34, v26
    v_mov_b32 v16, v26
    v_fma_f32 v72, v68, s34, -v1
    v_fma_f32 v73, v69, s34, -v1
    v_fma_f32 v74, v70, s34, -v1
    v_fma_f32 v75, v71, s34, -v1
    v_exp_f32 v72, v72
    v_exp_f32 v73, v73
    v_exp_f32 v74, v74
    v_exp_f32 v75, v75
    v_mul_f32 v17, v17, v27
    v_pk_mul_f32 v[8:9], v[8:9], v[26:27] op_sel:[0,1] op_sel_hi:[1,1]
    v_pk_mul_f32 v[10:11], v[10:11], v[26:27] op_sel:[0,1] op_sel_hi:[1,1]
    v_pk_mul_f32 v[12:13], v[12:13], v[26:27] op_sel:[0,1] op_sel_hi:[1,1]
    v_pk_mul_f32 v[14:15], v[14:15], v[26:27] op_sel:[0,1] op_sel_hi:[1,1]
    v_add_f32 v17, v17, v72
    v_add_f32 v17, v17, v73
    v_add_f32 v17, v17, v74
    v_add_f32 v17, v17, v75
    s_waitcnt lgkmcnt(0)
    v_readfirstlane_b32 s33, v28
    s_and_b32 s33, s33, 0xffffff
    s_cmp_ge_u32 s33, 256
    s_cbranch_scc1 L_tail
    s_mul_i32 s33, s33, 4096
    s_add_u32 s72, s33, 0
    s_cmp_lg_u32 s3, 0
    s_cbranch_scc1 L_noclk
    s_memrealtime s[46:47]
L_noclk:
    s_waitcnt vmcnt(3)
    v_lshlrev_b32 v18, 16, v52
    v_and_b32 v19, s37, v52
    v_lshlrev_b32 v20, 16, v53
    v_and_b32 v21, s37, v53
    v_lshlrev_b32 v22, 16, v54
    v_and_b32 v23, s37, v54
    v_lshlrev_b32 v24, 16, v55
    v_and_b32 v25, s37, v55
    buffer_load_dwordx4 v[36:39], v2, s[20:23], s72 offen offset:0 nt
    v_pk_fma_f32 v[8:9], v[18:19], v[72:73], v[8:9] op_sel:[0,0,0] op_sel_hi:[1,0,1]
    v_pk_fma_f32 v[10:11], v[20:21], v[72:73], v[10:11] op_sel:[0,0,0] op_sel_hi:[1,0,1]
    v_pk_fma_f32 v[12:13], v[22:23], v[72:73], v[12:13] op_sel:[0,0,0] op_sel_hi:[1,0,1]
    v_pk_fma_f32 v[14:15], v[24:25], v[72:73], v[14:15] op_sel:[0,0,0] op_sel_hi:[1,0,1]
    s_waitcnt vmcnt(3)
    v_lshlrev_b32 v18, 16, v56
    v_and_b32 v19, s37, v56
    v_lshlrev_b32 v20, 16, v57
    v_and_b32 v21, s37, v57
    v_lshlrev_b32 v22, 16, v58
    v_and_b32 v23, s37, v58
    v_lshlrev_b32 v24, 16, v59
    v_and_b32 v25, s37, v59
    buffer_load_dwordx4 v[40:43], v2, s[20:23], s72 offen offset:1024 nt
    v_pk_fma_f32 v[8:9], v[18:19], v[72:73], v[8:9] op_sel:[0,1,0] op_sel_hi:[1,1,1]
    v_pk_fma_f32 v[10:11], v[20:21], v[72:73], v[10:11] op_sel:[0,1,0] op_sel_hi:[1,1,1]
    v_pk_fma_f32 v[12:13], v[22:23], v[72:73], v[12:13] op_sel:[0,1,0] op_sel_hi:[1,1,1]
    v_pk_fma_f32 v[14:15], v[24:25], v[72:73], v[14:15] op_sel:[0,1,0] op_sel_hi:[1,1,1]
    s_waitcnt vmcnt(3)
    v_lshlrev_b32 v18, 16, v60
    v_and_b32 v19, s37, v60
    v_lshlrev_b32 v20, 16, v61
    v_and_b32 v21, s37, v61
    v_lshlrev_b32 v22, 16, v62
    v_and_b32 v23, s37, v62
    v_lshlrev_b32 v24, 16, v63
    v_and_b32 v25, s37, v63
    buffer_load_dwordx4 v[44:47], v2, s[20:23], s72 offen offset:2048 nt
    v_pk_fma_f32 v[8:9], v[18:19], v[74:75], v[8:9] op_sel:[0,0,0] op_sel_hi:[1,0,1]
    v_pk_fma_f32 v[10:11], v[20:21], v[74:75], v[10:11] op_sel:[0,0,0] op_sel_hi:[1,0,1]
    v_pk_fma_f32 v[12:13], v[22:23], v[74:75], v[12:13] op_sel:[0,0,0] op_sel_hi:[1,0,1]
    v_pk_fma_f32 v[14:15], v[24:25], v[74:75], v[14:15] op_sel:[0,0,0] op_sel_hi:[1,0,1]
    ds_read_b64 v[28:29], v30
    s_waitcnt vmcnt(3)
    v_lshlrev_b32 v18, 16, v64
    v_and_b32 v19, s37, v64
    v_lshlrev_b32 v20, 16, v65
    v_and_b32 v21, s37, v65
    v_lshlrev_b32 v22, 16, v66
    v_and_b32 v23, s37, v66
    v_lshlrev_b32 v24, 16, v67
    v_and_b32 v25, s37, v67
    buffer_load_dwordx4 v[48:51], v2, s[20:23], s72 offen offset:3072 nt
    v_pk_fma_f32 v[8:9], v[18:19], v[74:75], v[8:9] op_sel:[0,1,0] op_sel_hi:[1,1,1]
    v_pk_fma_f32 v[10:11], v[20:21], v[74:75], v[10:11] op_sel:[0,1,0] op_sel_hi:[1,1,1]
    v_pk_fma_f32 v[12:13], v[22:23], v[74:75], v[12:13] op_sel:[0,1,0] op_sel_hi:[1,1,1]
    v_pk_fma_f32 v[14:15], v[24:25], v[74:75], v[14:15] op_sel:[0,1,0] op_sel_hi:[1,1,1]
    s_mov_b64 exec, 1
    ds_add_u32 v30, v31 offset:4
    s_mov_b64 exec, -1
    s_mov_b32 s64, s72
    s_branch L_bound
L_park:
    s_waitcnt vmcnt(3)
    v_dot2_f32_bf16 v68, v36, v4, 0
    v_dot2_f32_bf16 v68, v37, v5, v68
    v_dot2_f32_bf16 v68, v38, v6, v68
    v_dot2_f32_bf16 v68, v39, v7, v68
    buffer_load_dwordx4 v[52:55], v2, s[24:27], s64 offen offset:0 nt
    s_waitcnt vmcnt(3)
    v_dot2_f32_bf16 v69, v40, v4, 0
    v_dot2_f32_bf16 v69, v41, v5, v69
    v_dot2_f32_bf16 v69, v42, v6, v69
    v_dot2_f32_bf16 v69, v43, v7, v69
    buffer_load_dwordx4 v[56:59], v2, s[24:27], s64 offen offset:1024 nt
    s_waitcnt vmcnt(3)
    v_dot2_f32_bf16 v70, v44, v4, 0
    v_dot2_f32_bf16 v70, v45, v5, v70
    v_dot2_f32_bf16 v70, v46, v6, v70
    v_dot2_f32_bf16 v70, v47, v7, v70
    buffer_load_dwordx4 v[60:63], v2, s[24:27], s64 offen offset:2048 nt
    s_waitcnt vmcnt(3)
    v_dot2_f32_bf16 v71, v48, v4, 0
    v_dot2_f32_bf16 v71, v49, v5, v71
    v_dot2_f32_bf16 v71, v50, v6, v71
    v_dot2_f32_bf16 v71, v51, v7, v71
    buffer_load_dwordx4 v[64:67], v2, s[24:27], s64 offen offset:3072 nt
    s_nop 1
    v_add_f32_dpp v68, v68, v68 quad_perm:[1,0,3,2] row_mask:0xf bank_mask:0xf
    v_add_f32_dpp v69, v69, v69 quad_perm:[1,0,3,2] row_mask:0xf bank_mask:0xf
    v_add_f32_dpp v70, v70, v70 quad_perm:[1,0,3,2] row_mask:0xf bank_mask:0xf
    v_add_f32_dpp v71, v71, v71 quad_perm:[1,0,3,2] row_mask:0xf bank_mask:0xf
    v_add_f32_dpp v68, v68, v68 quad_perm:[2,3,0,1] row_mask:0xf bank_mask:0xf
    v_add_f32_dpp v69, v69, v69 quad_perm:[2,3,0,1] row_mask:0xf bank_mask:0xf
    v_add_f32_dpp v70, v70, v70 quad_perm:[2,3,0,1] row_mask:0xf bank_mask:0xf
    v_add_f32_dpp v71, v71, v71 quad_perm:[2,3,0,1] row_mask:0xf bank_mask:0xf
    v_add_f32_dpp v68, v68, v68 row_half_mirror row_mask:0xf bank_mask:0xf
    v_add_f32_dpp v69, v69, v69 row_half_mirror row_mask:0xf bank_mask:0xf
    v_add_f32_dpp v70, v70, v70 row_half_mirror row_mask:0xf bank_mask:0xf
    v_add_f32_dpp v71, v71, v71 row_half_mirror row_mask:0xf bank_mask:0xf
    v_add_f32_dpp v68, v68, v68 row_mirror row_mask:0xf bank_mask:0xf
    v_add_f32_dpp v69, v69, v69 row_mirror row_mask:0xf bank_mask:0xf
    v_add_f32_dpp v70, v70, v70 row_mirror row_mask:0xf bank_mask:0xf
    v_add_f32_dpp v71, v71, v71 row_mirror row_mask:0xf bank_mask:0xf
    v_max3_f32 v26, v16, v68, v69
    v_max3_f32 v26, v26, v70, v71
    v_sub_f32 v27, v16, v26
    v_mul_f32 v27, s34, v27
    v_exp_f32 v27, v27
    v_mul_f32 v1, s34, v26
    v_mov_b32 v16, v26
    v_fma_f32 v72, v68, s34, -v1
    v_fma_f32 v73, v69, s34, -v1
    v_fma_f32 v74, v70, s34, -v1
    v_fma_f32 v75, v71, s34, -v1
    v_exp_f32 v72, v72
    v_exp_f32 v73, v73
    v_exp_f32 v74, v74
    v_exp_f32 v75, v75
    v_mul_f32 v17, v17, v27
    v_pk_mul_f32 v[8:9], v[8:9], v[26:27] op_sel:[0,1] op_sel_hi:[1,1]
    v_pk_mul_f32 v[10:11], v[10:11], v[26:27] op_sel:[0,1] op_sel_hi:[1,1]
    v_pk_mul_f32 v[12:13], v[12:13], v[26:27] op_sel:[0,1] op_sel_hi:[1,1]
    v_pk_mul_f32 v[14:15], v[14:15], v[26:27] op_sel:[0,1] op_sel_hi:[1,1]
    v_add_f32 v17, v17, v72
    v_add_f32 v17, v17, v73
    v_add_f32 v17, v17, v74
    v_add_f32 v17, v17, v75
    s_waitcnt vmcnt(3)
    v_lshlrev_b32 v18, 16, v52
    v_and_b32 v19, s37, v52
    v_lshlrev_b32 v20, 16, v53
    v_and_b32 v21, s37, v53
    v_lshlrev_b32 v22, 16, v54
    v_and_b32 v23, s37, v54
    v_lshlrev_b32 v24, 16, v55
    v_and_b32 v25, s37, v55
    v_pk_fma_f32 v[8:9], v[18:19], v[72:73], v[8:9] op_sel:[0,0,0] op_sel_hi:[1,0,1]
    v_pk_fma_f32 v[10:11], v[20:21], v[72:73], v[10:11] op_sel:[0,0,0] op_sel_hi:[1,0,1]
    v_pk_fma_f32 v[12:13], v[22:23], v[72:73], v[12:13] op_sel:[0,0,0] op_sel_hi:[1,0,1]
    v_pk_fma_f32 v[14:15], v[24:25], v[72:73], v[14:15] op_sel:[0,0,0] op_sel_hi:[1,0,1]
    s_waitcnt vmcnt(2)
    v_lshlrev_b32 v18, 16, v56
    v_and_b32 v19, s37, v56
    v_lshlrev_b32 v20, 16, v57
    v_and_b32 v21, s37, v57
    v_lshlrev_b32 v22, 16, v58
    v_and_b32 v23, s37, v58
    v_lshlrev_b32 v24, 16, v59
    v_and_b32 v25, s37, v59
    v_pk_fma_f32 v[8:9], v[18:19], v[72:73], v[8:9] op_sel:[0,1,0] op_sel_hi:[1,1,1]
    v_pk_fma_f32 v[10:11], v[20:21], v[72:73], v[10:11] op_sel:[0,1,0] op_sel_hi:[1,1,1]
    v_pk_fma_f32 v[12:13], v[22:23], v[72:73], v[12:13] op_sel:[0,1,0] op_sel_hi:[1,1,1]
    v_pk_fma_f32 v[14:15], v[24:25], v[72:73], v[14:15] op_sel:[0,1,0] op_sel_hi:[1,1,1]
    s_waitcnt vmcnt(1)
    v_lshlrev_b32 v18, 16, v60
    v_and_b32 v19, s37, v60
    v_lshlrev_b32 v20, 16, v61
    v_and_b32 v21, s37, v61
    v_lshlrev_b32 v22, 16, v62
    v_and_b32 v23, s37, v62
    v_lshlrev_b32 v24, 16, v63
    v_and_b32 v25, s37, v63
    v_pk_fma_f32 v[8:9], v[18:19], v[74:75], v[8:9] op_sel:[0,0,0] op_sel_hi:[1,0,1]
    v_pk_fma_f32 v[10:11], v[20:21], v[74:75], v[10:11] op_sel:[0,0,0] op_sel_hi:[1,0,1]
    v_pk_fma_f32 v[12:13], v[22:23], v[74:75], v[12:13] op_sel:[0,0,0] op_sel_hi:[1,0,1]
    v_pk_fma_f32 v[14:15], v[24:25], v[74:75], v[14:15] op_sel:[0,0,0] op_sel_hi:[1,0,1]
    s_waitcnt vmcnt(0)
    v_lshlrev_b32 v18, 16, v64
    v_and_b32 v19, s37, v64
    v_lshlrev_b32 v20, 16, v65
    v_and_b32 v21, s37, v65
    v_lshlrev_b32 v22, 16, v66
    v_and_b32 v23, s37, v66
    v_lshlrev_b32 v24, 16, v67
    v_and_b32 v25, s37, v67
    v_pk_fma_f32 v[8:9], v[18:19], v[74:75], v[8:9] op_sel:[0,1,0] op_sel_hi:[1,1,1]
    v_pk_fma_f32 v[10:11], v[20:21], v[74:75], v[10:11] op_sel:[0,1,0] op_sel_hi:[1,1,1]
    v_pk_fma_f32 v[12:13], v[22:23], v[74:75], v[12:13] op_sel:[0,1,0] op_sel_hi:[1,1,1]
    v_pk_fma_f32 v[14:15], v[24:25], v[74:75], v[14:15] op_sel:[0,1,0] op_sel_hi:[1,1,1]
    s_mov_b64 exec, 1
    ds_add_u32 v30, v31 offset:4
    s_mov_b64 exec, -1
L_spin:
    ds_read_b32 v28, v30
    s_waitcnt lgkmcnt(0)
    v_readfirstlane_b32 s33, v28
    s_and_b32 s35, s33, 0xffffff
    s_cmp_ge_u32 s35, 256
    s_cbranch_scc1 L_epi
    s_lshr_b32 s33, s33, 24
    s_cmp_ge_u32 s3, s33
    s_cbranch_scc1 L_spin
    s_mov_b64 exec, 1
    ds_add_rtn_u32 v28, v30, v31
    s_mov_b64 exec, -1
    s_waitcnt lgkmcnt(0)
    v_readfirstlane_b32 s33, v28
    s_and_b32 s33, s33, 0xffffff
    s_cmp_ge_u32 s33, 256
    s_cbranch_scc1 L_epi
    s_mul_i32 s33, s33, 4096
    s_add_u32 s64, s33, 0
    buffer_load_dwordx4 v[36:39], v2, s[20:23], s64 offen offset:0 nt
    buffer_load_dwordx4 v[40:43], v2, s[20:23], s64 offen offset:1024 nt
    buffer_load_dwordx4 v[44:47], v2, s[20:23], s64 offen offset:2048 nt
    buffer_load_dwordx4 v[48:51], v2, s[20:23], s64 offen offset:3072 nt
    s_branch L_go
L_tail:
    s_waitcnt vmcnt(3)
    v_lshlrev_b32 v18, 16, v52
    v_and_b32 v19, s37, v52
    v_lshlrev_b32 v20, 16, v53
    v_and_b32 v21, s37, v53
    v_lshlrev_b32 v22, 16, v54
    v_and_b32 v23, s37, v54
    v_lshlrev_b32 v24, 16, v55
    v_and_b32 v25, s37, v55
    v_pk_fma_f32 v[8:9], v[18:19], v[72:73], v[8:9] op_sel:[0,0,0] op_sel_hi:[1,0,1]
    v_pk_fma_f32 v[10:11], v[20:21], v[72:73], v[10:11] op_sel:[0,0,0] op_sel_hi:[1,0,1]
    v_pk_fma_f32 v[12:13], v[22:23], v[72:73], v[12:13] op_sel:[0,0,0] op_sel_hi:[1,0,1]
    v_pk_fma_f32 v[14:15], v[24:25], v[72:73], v[14:15] op_sel:[0,0,0] op_sel_hi:[1,0,1]
    s_waitcnt vmcnt(2)
    v_lshlrev_b32 v18, 16, v56
    v_and_b32 v19, s37, v56
    v_lshlrev_b32 v20, 16, v57
    v_and_b32 v21, s37, v57
    v_lshlrev_b32 v22, 16, v58
    v_and_b32 v23, s37, v58
    v_lshlrev_b32 v24, 16, v59
    v_and_b32 v25, s37, v59
    v_pk_fma_f32 v[8:9], v[18:19], v[72:73], v[8:9] op_sel:[0,1,0] op_sel_hi:[1,1,1]
    v_pk_fma_f32 v[10:11], v[20:21], v[72:73], v[10:11] op_sel:[0,1,0] op_sel_hi:[1,1,1]
    v_pk_fma_f32 v[12:13], v[22:23], v[72:73], v[12:13] op_sel:[0,1,0] op_sel_hi:[1,1,1]
    v_pk_fma_f32 v[14:15], v[24:25], v[72:73], v[14:15] op_sel:[0,1,0] op_sel_hi:[1,1,1]
    s_waitcnt vmcnt(1)
    v_lshlrev_b32 v18, 16, v60
    v_and_b32 v19, s37, v60
    v_lshlrev_b32 v20, 16, v61
    v_and_b32 v21, s37, v61
    v_lshlrev_b32 v22, 16, v62
    v_and_b32 v23, s37, v62
    v_lshlrev_b32 v24, 16, v63
    v_and_b32 v25, s37, v63
    v_pk_fma_f32 v[8:9], v[18:19], v[74:75], v[8:9] op_sel:[0,0,0] op_sel_hi:[1,0,1]
    v_pk_fma_f32 v[10:11], v[20:21], v[74:75], v[10:11] op_sel:[0,0,0] op_sel_hi:[1,0,1]
    v_pk_fma_f32 v[12:13], v[22:23], v[74:75], v[12:13] op_sel:[0,0,0] op_sel_hi:[1,0,1]
    v_pk_fma_f32 v[14:15], v[24:25], v[74:75], v[14:15] op_sel:[0,0,0] op_sel_hi:[1,0,1]
    s_waitcnt vmcnt(0)
    v_lshlrev_b32 v18, 16, v64
    v_and_b32 v19, s37, v64
    v_lshlrev_b32 v20, 16, v65
    v_and_b32 v21, s37, v65
    v_lshlrev_b32 v22, 16, v66
    v_and_b32 v23, s37, v66
    v_lshlrev_b32 v24, 16, v67
    v_and_b32 v25, s37, v67
    v_pk_fma_f32 v[8:9], v[18:19], v[74:75], v[8:9] op_sel:[0,1,0] op_sel_hi:[1,1,1]
    v_pk_fma_f32 v[10:11], v[20:21], v[74:75], v[10:11] op_sel:[0,1,0] op_sel_hi:[1,1,1]
    v_pk_fma_f32 v[12:13], v[22:23], v[74:75], v[12:13] op_sel:[0,1,0] op_sel_hi:[1,1,1]
    v_pk_fma_f32 v[14:15], v[24:25], v[74:75], v[14:15] op_sel:[0,1,0] op_sel_hi:[1,1,1]
L_epi:
    v_mov_b32 v26, v16
    v_mov_b32 v27, v26
    s_nop 1
    v_permlane32_swap_b32 v26, v27
    s_nop 1
    v_max_f32 v26, v26, v27
    v_mov_b32 v27, v26
    s_nop 1
    v_permlane16_swap_b32 v26, v27
    s_nop 1
    v_max_f32 v26, v26, v27
    v_sub_f32 v27, v16, v26
    v_mul_f32 v27, s34, v27
    v_exp_f32 v27, v27
    s_nop 0
    v_mul_f32 v17, v17, v27
    v_mul_f32 v8, v8, v27
    v_mul_f32 v9, v9, v27
    v_mul_f32 v10, v10, v27
    v_mul_f32 v11, v11, v27
    v_mul_f32 v12, v12, v27
    v_mul_f32 v13, v13, v27
    v_mul_f32 v14, v14, v27
    v_mul_f32 v15, v15, v27
    v_mov_b32 v28, v17
    s_nop 1
    v_permlane32_swap_b32 v17, v28
    s_nop 1
    v_add_f32 v17, v17, v28
    v_mov_b32 v28, v17
    s_nop 1
    v_permlane16_swap_b32 v17, v28
    s_nop 1
    v_add_f32 v17, v17, v28
    v_mov_b32 v28, v8
    s_nop 1
    v_permlane32_swap_b32 v8, v28
    s_nop 1
    v_add_f32 v8, v8, v28
    v_mov_b32 v28, v8
    s_nop 1
    v_permlane16_swap_b32 v8, v28
    s_nop 1
    v_add_f32 v8, v8, v28
    v_mov_b32 v28, v9
    s_nop 1
    v_permlane32_swap_b32 v9, v28
    s_nop 1
    v_add_f32 v9, v9, v28
    v_mov_b32 v28, v9
    s_nop 1
    v_permlane16_swap_b32 v9, v28
    s_nop 1
    v_add_f32 v9, v9, v28
    v_mov_b32 v28, v10
    s_nop 1
    v_permlane32_swap_b32 v10, v28
    s_nop 1
    v_add_f32 v10, v10, v28
    v_mov_b32 v28, v10
    s_nop 1
    v_permlane16_swap_b32 v10, v28
    s_nop 1
    v_add_f32 v10, v10, v28
    v_mov_b32 v28, v11
    s_nop 1
    v_permlane32_swap_b32 v11, v28
    s_nop 1
    v_add_f32 v11, v11, v28
    v_mov_b32 v28, v11
    s_nop 1
    v_permlane16_swap_b32 v11, v28
    s_nop 1
    v_add_f32 v11, v11, v28
    v_mov_b32 v28, v12
    s_nop 1
    v_permlane32_swap_b32 v12, v28
    s_nop 1
    v_add_f32 v12, v12, v28
    v_mov_b32 v28, v12
    s_nop 1
    v_permlane16_swap_b32 v12, v28
    s_nop 1
    v_add_f32 v12, v12, v28
    v_mov_b32 v28, v13
    s_nop 1
    v_permlane32_swap_b32 v13, v28
    s_nop 1
    v_add_f32 v13, v13, v28
    v_mov_b32 v28, v13
    s_nop 1
    v_permlane16_swap_b32 v13, v28
    s_nop 1
    v_add_f32 v13, v13, v28
    v_mov_b32 v28, v14
    s_nop 1
    v_permlane32_swap_b32 v14, v28
    s_nop 1
    v_add_f32 v14, v14, v28
    v_mov_b32 v28, v14
    s_nop 1
    v_permlane16_swap_b32 v14, v28
    s_nop 1
    v_add_f32 v14, v14, v28
    v_mov_b32 v28, v15
    s_nop 1
    v_permlane32_swap_b32 v15, v28
    s_nop 1
    v_add_f32 v15, v15, v28
    v_mov_b32 v28, v15
    s_nop 1
    v_permlane16_swap_b32 v15, v28
    s_nop 1
    v_add_f32 v15, v15, v28
    s_lshl_b32 s39, s3, 9
    v_lshlrev_b32 v29, 1, v3
    v_add_u32 v29, s39, v29
    s_lshl_b32 s40, s3, 3
    s_add_u32 s40, s40, 8192
    v_mov_b32 v30, s40
    v_mov_b32 v27, v17
    v_cmp_gt_u32 vcc, 256, v2
    s_and_saveexec_b64 s[42:43], vcc
    ds_write_b128 v29, v[8:11]
    ds_write_b128 v29, v[12:15] offset:16
    ds_write_b64 v30, v[26:27]
    s_mov_b64 exec, s[42:43]
    s_waitcnt vmcnt(0) lgkmcnt(0)
    s_barrier
    s_cmp_ge_u32 s3, 2
    s_cbranch_scc1 L_done
    v_lshlrev_b32 v1, 2, v0
    v_mov_b32 v3, 8192
    ds_read_b128 v[32:35], v3 offset:0
    ds_read_b128 v[36:39], v3 offset:16
    ds_read_b128 v[40:43], v3 offset:32
    ds_read_b128 v[44:47], v3 offset:48
    ds_read_b128 v[48:51], v3 offset:64
    ds_read_b128 v[52:55], v3 offset:80
    ds_read_b128 v[56:59], v3 offset:96
    ds_read_b128 v[60:63], v3 offset:112
    ds_read_b32 v64, v1 offset:0
    ds_read_b32 v65, v1 offset:512
    ds_read_b32 v66, v1 offset:1024
    ds_read_b32 v67, v1 offset:1536
    ds_read_b32 v68, v1 offset:2048
    ds_read_b32 v69, v1 offset:2560
    ds_read_b32 v70, v1 offset:3072
    ds_read_b32 v71, v1 offset:3584
    ds_read_b32 v72, v1 offset:4096
    ds_read_b32 v73, v1 offset:4608
    ds_read_b32 v74, v1 offset:5120
    ds_read_b32 v75, v1 offset:5632
    ds_read_b32 v76, v1 offset:6144
    ds_read_b32 v77, v1 offset:6656
    ds_read_b32 v78, v1 offset:7168
    ds_read_b32 v79, v1 offset:7680
    s_waitcnt lgkmcnt(0)
    v_mov_b32 v4, v32
    v_max_f32 v4, v4, v34
    v_max_f32 v4, v4, v36
    v_max_f32 v4, v4, v38
    v_max_f32 v4, v4, v40
    v_max_f32 v4, v4, v42
    v_max_f32 v4, v4, v44
    v_max_f32 v4, v4, v46
    v_max_f32 v4, v4, v48
    v_max_f32 v4, v4, v50
    v_max_f32 v4, v4, v52
    v_max_f32 v4, v4, v54
    v_max_f32 v4, v4, v56
    v_max_f32 v4, v4, v58
    v_max_f32 v4, v4, v60
    v_max_f32 v4, v4, v62
    v_sub_f32 v32, v32, v4
    v_sub_f32 v34, v34, v4
    v_sub_f32 v36, v36, v4
    v_sub_f32 v38, v38, v4
    v_sub_f32 v40, v40, v4
    v_sub_f32 v42, v42, v4
    v_sub_f32 v44, v44, v4
    v_sub_f32 v46, v46, v4
    v_sub_f32 v48, v48, v4
    v_sub_f32 v50, v50, v4
    v_sub_f32 v52, v52, v4
    v_sub_f32 v54, v54, v4
    v_sub_f32 v56, v56, v4
    v_sub_f32 v58, v58, v4
    v_sub_f32 v60, v60, v4
    v_sub_f32 v62, v62, v4
    v_mul_f32 v32, s34, v32
    v_mul_f32 v34, s34, v34
    v_mul_f32 v36, s34, v36
    v_mul_f32 v38, s34, v38
    v_mul_f32 v40, s34, v40
    v_mul_f32 v42, s34, v42
    v_mul_f32 v44, s34, v44
    v_mul_f32 v46, s34, v46
    v_mul_f32 v48, s34, v48
    v_mul_f32 v50, s34, v50
    v_mul_f32 v52, s34, v52
    v_mul_f32 v54, s34, v54
    v_mul_f32 v56, s34, v56
    v_mul_f32 v58, s34, v58
    v_mul_f32 v60, s34, v60
    v_mul_f32 v62, s34, v62
    v_exp_f32 v32, v32
    v_exp_f32 v34, v34
    v_exp_f32 v36, v36
    v_exp_f32 v38, v38
    v_exp_f32 v40, v40
    v_exp_f32 v42, v42
    v_exp_f32 v44, v44
    v_exp_f32 v46, v46
    v_exp_f32 v48, v48
    v_exp_f32 v50, v50
    v_exp_f32 v52, v52
    v_exp_f32 v54, v54
    v_exp_f32 v56, v56
    v_exp_f32 v58, v58
    v_exp_f32 v60, v60
    v_exp_f32 v62, v62
    v_mov_b32 v5, 0
    v_mov_b32 v6, 0
    v_fmac_f32 v5, v32, v33
    v_fmac_f32 v6, v32, v64
    v_fmac_f32 v5, v34, v35
    v_fmac_f32 v6, v34, v65
    v_fmac_f32 v5, v36, v37
    v_fmac_f32 v6, v36, v66
    v_fmac_f32 v5, v38, v39
    v_fmac_f32 v6, v38, v67
    v_fmac_f32 v5, v40, v41
    v_fmac_f32 v6, v40, v68
    v_fmac_f32 v5, v42, v43
    v_fmac_f32 v6, v42, v69
    v_fmac_f32 v5, v44, v45
    v_fmac_f32 v6, v44, v70
    v_fmac_f32 v5, v46, v47
    v_fmac_f32 v6, v46, v71
    v_fmac_f32 v5, v48, v49
    v_fmac_f32 v6, v48, v72
    v_fmac_f32 v5, v50, v51
    v_fmac_f32 v6, v50, v73
    v_fmac_f32 v5, v52, v53
    v_fmac_f32 v6, v52, v74
    v_fmac_f32 v5, v54, v55
    v_fmac_f32 v6, v54, v75
    v_fmac_f32 v5, v56, v57
    v_fmac_f32 v6, v56, v76
    v_fmac_f32 v5, v58, v59
    v_fmac_f32 v6, v58, v77
    v_fmac_f32 v5, v60, v61
    v_fmac_f32 v6, v60, v78
    v_fmac_f32 v5, v62, v63
    v_fmac_f32 v6, v62, v79
    v_rcp_f32 v5, v5
    s_nop 0
    v_mul_f32 v6, v6, v5
    v_cvt_pk_bf16_f32 v6, v6, v6
    v_lshlrev_b32 v1, 1, v0
    buffer_store_short v6, v1, s[28:31], 0 offen
L_done:
    s_endpgm
.section .rodata,"a"
.p2align 6
.amdhsa_kernel standalone__softmax_full_bidir__decode_kernel
  .amdhsa_next_free_vgpr 80
  .amdhsa_next_free_sgpr 100
  .amdhsa_accum_offset 80
  .amdhsa_group_segment_fixed_size 0
  .amdhsa_kernarg_size 48
  .amdhsa_user_sgpr_count 2
  .amdhsa_user_sgpr_kernarg_segment_ptr 1
  .amdhsa_system_sgpr_workgroup_id_x 1
.end_amdhsa_kernel
```
